```python
import torch

def _softmax(x, axis=-1):
    return torch.softmax(x, dim=axis)
def _gelu(x):
    return torch.nn.functional.gelu(x, approximate="tanh")
def _silu(x):
    return torch.nn.functional.silu(x)
def _sigmoid(x):
    return torch.sigmoid(x)
def _layernorm(x, axis=-1, eps=1e-5):
    m = x.mean(dim=axis, keepdim=True)
    v = x.var(dim=axis, keepdim=True, unbiased=False)
    return (x - m) / torch.sqrt(v + eps)
def _scatter_add(tgt, idx, src, axis=0):
    return tgt.clone().index_add_(axis, idx, src)
def _segment_sum(src, seg, n):
    out = torch.zeros((n,) + src.shape[1:], dtype=src.dtype)
    return out.index_add_(0, seg, src)
def _pad(x, pw):
    flat = tuple(v for pair in reversed(pw) for v in pair)
    return torch.nn.functional.pad(x, flat)

kernel_name = 'standalone__kv_cache_quant_int4_int2_kv_with_per_channel_or_per_token_scales__decode'

def setup_inputs():

    _w = (lambda a: (lambda t: t.to(torch.bfloat16) if t.is_floating_point() else t)(torch.as_tensor(a)))
    B = 2
    Sq = 1
    Skv = 32768
    Hq = 32
    Hkv = 16
    Dh = 128
    bits = 2
    G = -1
    if G <= 0 or G >= Skv:
        G = max(1, Skv // 2)
    Skv = (Skv // G) * G
    ngk = Skv // G
    qmax = (1 << bits) - 1
    return {
        "q": _w((lambda *s: torch.randn(*s, dtype=torch.bfloat16) * 3.2)(B, Hq, Sq, Dh)),
        "qk": _w(torch.randint(0, qmax + 1, (B, Hkv, Skv, Dh)).to(torch.int32)),
        "qv": _w(torch.randint(0, qmax + 1, (B, Hkv, Skv, Dh)).to(torch.int32)),
        "k_scales": _w(torch.abs((lambda *s: torch.randn(*s, dtype=torch.bfloat16) * 3.2)(B, Hkv, ngk, Dh)) * 0.05 + 0.02),
        "k_zeros": _w((lambda *s: torch.randn(*s, dtype=torch.bfloat16) * 3.2)(B, Hkv, ngk, Dh) + float(qmax) / 2.0),
        "v_scales": _w(torch.abs((lambda *s: torch.randn(*s, dtype=torch.bfloat16) * 0.05)(B, Hkv, Skv, 1)) * 0.05 + 0.02),
        "v_zeros": _w((lambda *s: torch.randn(*s, dtype=torch.bfloat16) * 0.05)(B, Hkv, Skv, 1) + float(qmax) / 2.0),
    }

def reference(q, qk, qv, k_scales, k_zeros, v_scales, v_zeros):
    B, Hq, Sq, Dh = q.shape
    Hkv, Skv = qk.shape[1], qk.shape[2]
    ngk = k_scales.shape[2]
    G = Skv // ngk
    ks = (lambda x, n, axis: torch.repeat_interleave(x, n, dim=axis))(k_scales, G, axis=2)
    kz = (lambda x, n, axis: torch.repeat_interleave(x, n, dim=axis))(k_zeros, G, axis=2)
    k = ((lambda x, dt: x.to(dt))(qk, q.dtype) - kz) * ks
    v = ((lambda x, dt: x.to(dt))(qv, q.dtype) - v_zeros) * v_scales
    rep = Hq // Hkv
    if rep > 1:
        k = (lambda x, n, axis: torch.repeat_interleave(x, n, dim=axis))(k, rep, axis=1)
        v = (lambda x, n, axis: torch.repeat_interleave(x, n, dim=axis))(v, rep, axis=1)
    scale = float(Dh) ** -0.5
    logits = torch.einsum("bhqd,bhkd->bhqk", q, k) * scale
    p = _softmax(logits, axis=-1)
    o = torch.einsum("bhqk,bhkd->bhqd", p, v)
    return o
```

```asm
; @launch grid=(256,1,1) block=(256,1,1) lds=57424
.amdgcn_target "amdgcn-amd-amdhsa--gfx950"
.text
.globl standalone__kv_cache_quant_int4_int2_kv_with_per_channel_or_per_token_scales__decode_kernel
.p2align 8
.type standalone__kv_cache_quant_int4_int2_kv_with_per_channel_or_per_token_scales__decode_kernel,@function
standalone__kv_cache_quant_int4_int2_kv_with_per_channel_or_per_token_scales__decode_kernel:
    s_cmp_ge_u32 s2, 256
    s_cbranch_scc1 L_end
    s_load_dwordx4 s[4:7], s[0:1], 0
    s_load_dwordx4 s[8:11], s[0:1], 16
    s_load_dwordx8 s[12:19], s[0:1], 32
    s_load_dwordx4 s[20:23], s[0:1], 64
    s_getpc_b64 s[70:71]
L_pc:
    v_lshlrev_b32 v248, 6, v0
    v_min_u32 v248, L_last-L_pc, v248
    global_load_dword v249, v248, s[70:71]
    v_and_b32 v7, 63, v0
    v_lshrrev_b32 v204, 6, v0
    v_and_b32 v205, 15, v7
    v_lshrrev_b32 v206, 4, v7
    v_readfirstlane_b32 s56, v204
    v_lshrrev_b32 v207, 2, v205
    v_and_b32 v208, 3, v205
    v_and_b32 v209, 1, v206
    v_lshrrev_b32 v210, 1, v206
    v_lshlrev_b32 v213, 15, v207
    v_lshl_add_u32 v213, v210, 9, v213
    v_lshl_add_u32 v213, v209, 6, v213
    v_lshl_add_u32 v1, v208, 4, v213
    v_lshlrev_b32 v216, 3, v7
    v_and_b32 v215, 0xff, v216
    v_lshlrev_b32 v94, 4, v7
    s_lshr_b32 s57, s2, 2
    s_lshr_b32 s64, s2, 3
    s_lshl_b32 s65, s2, 9
    s_add_u32 s65, s65, s56
    s_lshl_b32 s65, s65, 12
    s_lshl_b32 s62, s64, 9
    s_lshl_b32 s63, s57, 8
    s_mov_b32 s27, 0x00020000
    s_mov_b32 s43, 0x00020000
    s_mov_b32 s47, 0x00020000
    s_mov_b32 s51, 0x00020000
    s_mov_b32 s35, 0x00020000
    s_mov_b32 s39, 0x00020000
    s_mov_b32 s55, 0x00020000
    s_mov_b32 s26, 0x20000000
    s_mov_b32 s42, 0x4000
    s_mov_b32 s46, 0x4000
    s_mov_b32 s50, 0x4000
    s_mov_b32 s34, 0x200000
    s_mov_b32 s38, 0x200000
    s_mov_b32 s54, 0x104000
    s_lshl_b32 s61, s2, 13
    s_lshl_b32 s60, s56, 11
    s_add_u32 s61, s61, s60
    s_add_u32 m0, s60, 32768
    s_waitcnt lgkmcnt(0)
    s_mov_b32 s24, s6
    s_and_b32 s25, s7, 0xffff
    buffer_load_dwordx4 v[132:135], v1, s[24:27], s65 offen offset:0 nt
    buffer_load_dwordx4 v[136:139], v1, s[24:27], s65 offen offset:1024 nt
    buffer_load_dwordx4 v[140:143], v1, s[24:27], s65 offen offset:2048 nt
    buffer_load_dwordx4 v[144:147], v1, s[24:27], s65 offen offset:3072 nt
    buffer_load_dwordx4 v[148:151], v1, s[24:27], s65 offen offset:128 nt
    buffer_load_dwordx4 v[152:155], v1, s[24:27], s65 offen offset:1152 nt
    s_mov_b32 s40, s4
    s_and_b32 s41, s5, 0xffff
    s_mov_b32 s44, s10
    s_and_b32 s45, s11, 0xffff
    s_mov_b32 s48, s12
    s_and_b32 s49, s13, 0xffff
    buffer_load_dwordx2 v[196:197], v216, s[40:43], s62 offen
    buffer_load_dwordx2 v[198:199], v215, s[44:47], s63 offen
    buffer_load_dwordx2 v[200:201], v215, s[48:51], s63 offen
    s_mov_b32 s32, s14
    s_and_b32 s33, s15, 0xffff
    s_mov_b32 s36, s16
    s_and_b32 s37, s17, 0xffff
    buffer_load_dwordx4 v94, s[32:35], s61 offen offset:0 nt lds
    buffer_load_dwordx4 v94, s[32:35], s61 offen offset:1024 nt lds
    s_add_u32 m0, s60, 40960
    s_mov_b32 s52, s22
    s_and_b32 s53, s23, 0xffff
    buffer_load_dwordx4 v94, s[36:39], s61 offen offset:0 nt lds
    buffer_load_dwordx4 v94, s[36:39], s61 offen offset:1024 nt lds
    s_mov_b32 s96, s6
    s_and_b32 s97, s7, 0xffff
    s_mov_b32 s98, 0x20000000
    s_mov_b32 s99, 0x00020000
    s_mov_b32 s68, 0xffff0000
    s_mov_b32 s69, 0x3e0293ee
    v_and_b32 v211, 1, v205
    v_bfe_u32 v212, v205, 1, 1
    v_mov_b32 v3, v1
    v_lshl_add_u32 v213, v206, 2, v208
    v_lshlrev_b32 v213, 4, v213
    v_lshl_add_u32 v6, v204, 13, v213
    v_xor_b32 v213, v212, v210
    v_lshl_add_u32 v217, v209, 2, v207
    v_lshl_add_u32 v217, v211, 5, v217
    v_lshl_add_u32 v217, v213, 6, v217
    v_lshl_add_u32 v217, v204, 7, v217
    v_lshlrev_b32 v217, 4, v217
    v_add_u32 v217, 49152, v217
    v_lshl_add_u32 v216, v204, 11, v94
    v_mov_b32 v128, 0
    v_mov_b32 v129, 0
    v_mov_b32 v130, 0
    v_mov_b32 v131, 0
    v_cmp_gt_u32 s[66:67], 4, v205
    v_cmp_ne_u32 s[80:81], 0, v211
    ds_write_b128 v216, v[128:131] offset:50176
    v_mov_b32 v4, 0
    ds_write_b64 v128, v[128:129] offset:57408
    v_mov_b32 v8, 0xff7fffff
    s_mov_b32 s100, 0x50000
    s_mov_b32 s101, 0x50000
    s_or_b32 s62, s2, s56
    s_cmp_eq_u32 s62, 0
    s_cbranch_scc1 L_init
L_noinit:
    s_mov_b32 s58, s65
    s_mov_b32 s60, 0x4000
    s_mov_b32 s5, 0
    s_mov_b32 s13, 0
    s_mov_b32 s12, 0
    s_mov_b32 s10, 0
    s_mov_b32 s3, 0
    s_mov_b64 s[28:29], 0
    s_mov_b64 s[30:31], 0
    s_mov_b64 s[40:41], 0
    s_and_b32 s62, s2, 0x38
    s_lshr_b32 s63, s2, 6
    s_xor_b32 s63, s63, s56
    s_or_b32 s62, s62, s63
    s_cmp_eq_u32 s62, 0
    s_cselect_b32 s46, 0x44444444, 0
    s_cselect_b32 s47, 0x4444444, 0
    s_or_b32 s92, s46, 0x3111113a
    s_or_b32 s93, s47, 0x1111b111
    s_waitcnt lgkmcnt(0)
    s_barrier
    s_waitcnt vmcnt(4)
    buffer_load_dwordx4 v[156:159], v1, s[24:27], s65 offen offset:2176 nt
    v_lshlrev_b32 v72, 16, v196
    v_and_b32 v73, s68, v196
    v_lshlrev_b32 v74, 16, v198
    v_and_b32 v75, s68, v198
    v_lshlrev_b32 v76, 16, v200
    v_and_b32 v77, s68, v200
    v_mul_f32 v72, v72, v74
    v_mul_f32 v73, v73, v75
    v_mul_f32 v72, s69, v72
    v_mul_f32 v73, s69, v73
    v_cvt_pk_bf16_f32 v80, v72, v73
    v_mul_f32 v11, v72, v76
    v_fmac_f32 v11, v73, v77
    v_lshlrev_b32 v78, 16, v80
    v_and_b32 v79, s68, v80
    v_sub_f32 v72, v72, v78
    v_sub_f32 v73, v73, v79
    v_cvt_pk_bf16_f32 v82, v72, v73
    v_lshlrev_b32 v72, 16, v197
    v_and_b32 v73, s68, v197
    v_lshlrev_b32 v74, 16, v199
    v_and_b32 v75, s68, v199
    v_lshlrev_b32 v76, 16, v201
    v_and_b32 v77, s68, v201
    v_mul_f32 v72, v72, v74
    v_mul_f32 v73, v73, v75
    v_mul_f32 v72, s69, v72
    v_mul_f32 v73, s69, v73
    v_cvt_pk_bf16_f32 v81, v72, v73
    v_fmac_f32 v11, v72, v76
    v_fmac_f32 v11, v73, v77
    v_lshlrev_b32 v78, 16, v81
    v_and_b32 v79, s68, v81
    v_sub_f32 v72, v72, v78
    v_sub_f32 v73, v73, v79
    v_cvt_pk_bf16_f32 v83, v72, v73
    ds_write_b128 v216, v[80:83] offset:49152
    s_waitcnt vmcnt(4)
    buffer_load_dwordx4 v[160:163], v1, s[24:27], s65 offen offset:3200 nt
    ds_read2_b64 v[16:19], v217 offset0:0 offset1:16
    ds_read2_b64 v[20:23], v217 offset0:1 offset1:17
    ds_read2_b64 v[24:27], v217 offset0:32 offset1:48
    ds_read2_b64 v[28:31], v217 offset0:33 offset1:49
    v_add_f32_dpp v11, v11, v11 row_ror:1 row_mask:0xf bank_mask:0xf
    s_nop 1
    v_add_f32_dpp v11, v11, v11 row_ror:2 row_mask:0xf bank_mask:0xf
    s_nop 1
    v_add_f32_dpp v11, v11, v11 row_ror:4 row_mask:0xf bank_mask:0xf
    s_nop 1
    v_add_f32_dpp v11, v11, v11 row_ror:8 row_mask:0xf bank_mask:0xf
    s_nop 1
    v_mov_b32 v10, v11
    s_nop 1
    v_permlane16_swap_b32 v11, v10
    s_nop 1
    v_add_f32 v11, v11, v10
    v_mul_f32 v11, 0xbe800000, v11
    s_nop 0
    v_readlane_b32 s62, v11, 0
    v_readlane_b32 s63, v11, 32
    s_nop 1
    v_mov_b32 v32, s62
    v_mov_b32 v10, s63
    v_cndmask_b32 v32, v32, v10, s[80:81]
    v_mov_b32 v33, v32
    v_mov_b32 v34, v32
    v_mov_b32 v35, v32
    .p2align 6
L_kloop:
    s_add_u32 s59, s58, s60
    s_xor_b32 s60, s60, 0x18000
    s_cmp_eq_u32 s13, 31
    s_cbranch_scc1 L_lastk
L_lastkb:
    s_waitcnt lgkmcnt(0)
    s_lshl_b32 s11, s40, 5
    s_sub_u32 s11, s11, s12
    s_add_u32 s12, s12, s10
    s_and_b32 s11, s11, s29
    s_mov_b32 s4, 0
    s_cmp_gt_i32 s11, 1920
    s_cselect_b32 s4, 16, s4
    s_cmp_lt_i32 s11, -800
    s_cselect_b32 s4, -1, s4
    s_cmp_lt_i32 s11, -1600
    s_cselect_b32 s4, -2, s4
    s_cmp_lt_i32 s11, -2560
    s_cselect_b32 s4, -3, s4
    s_add_u32 s30, s30, 1
    s_min_u32 s30, s30, 4
    s_cmp_ge_u32 s30, 2
    s_cselect_b32 s63, 64, 0
    s_min_i32 s4, s4, s63
    s_cmp_gt_i32 s4, 0
    s_cselect_b32 s63, 2, 0
    s_sub_u32 s30, s30, s63
    s_cmp_gt_i32 s11, 2880
    s_cselect_b32 s4, 16, s4
    s_cmp_gt_i32 s4, 16
    s_cbranch_scc1 L_kw0_2
    s_cmp_gt_i32 s4, 0
    s_cbranch_scc1 L_kw0_1
    s_cmp_lt_i32 s4, 0
    s_cbranch_scc0 L_kw0_0
    s_waitcnt vmcnt(3)
L_kw0_0:
    s_waitcnt vmcnt(4)
L_kw0_1:
    s_waitcnt vmcnt(5)
L_kw0_2:
    s_waitcnt vmcnt(6)
    buffer_load_dwordx4 v[164:167], v1, s[24:27], s58 offen offset:256 nt
    s_bitcmp1_b64 s[92:93], s13
    s_cbranch_scc1 L_ckk
L_nckk:
    s_add_u32 s13, s13, 1
    v_cvt_f32_i32 v132, v132
    v_cvt_f32_i32 v133, v133
    v_cvt_f32_i32 v134, v134
    v_cvt_f32_i32 v135, v135
    v_cvt_pk_bf16_f32 v36, v132, v133
    v_cvt_pk_bf16_f32 v37, v134, v135
    s_cmp_gt_i32 s4, 24
    s_cbranch_scc1 L_kw1_2
    s_cmp_gt_i32 s4, 8
    s_cbranch_scc1 L_kw1_1
L_kw1_0:
    s_waitcnt vmcnt(4)
L_kw1_1:
    s_waitcnt vmcnt(5)
L_kw1_2:
    s_waitcnt vmcnt(6)
    buffer_load_dwordx4 v[168:171], v1, s[24:27], s58 offen offset:1280 nt
    v_cvt_f32_i32 v136, v136
    v_cvt_f32_i32 v137, v137
    v_cvt_f32_i32 v138, v138
    v_cvt_f32_i32 v139, v139
    v_cvt_pk_bf16_f32 v40, v136, v137
    v_cvt_pk_bf16_f32 v41, v138, v139
    s_cmp_gt_i32 s4, 20
    s_cbranch_scc1 L_kw2_2
    s_cmp_gt_i32 s4, 4
    s_cbranch_scc1 L_kw2_1
L_kw2_0:
    s_waitcnt vmcnt(4)
L_kw2_1:
    s_waitcnt vmcnt(5)
L_kw2_2:
    s_waitcnt vmcnt(6)
    buffer_load_dwordx4 v[172:175], v1, s[24:27], s58 offen offset:2304 nt
    v_cvt_f32_i32 v140, v140
    v_cvt_f32_i32 v141, v141
    v_cvt_f32_i32 v142, v142
    v_cvt_f32_i32 v143, v143
    v_cvt_pk_bf16_f32 v44, v140, v141
    v_cvt_pk_bf16_f32 v45, v142, v143
    s_cmp_gt_i32 s4, 28
    s_cbranch_scc1 L_kw3_2
    s_cmp_gt_i32 s4, 12
    s_cbranch_scc1 L_kw3_1
L_kw3_0:
    s_waitcnt vmcnt(4)
L_kw3_1:
    s_waitcnt vmcnt(5)
L_kw3_2:
    s_waitcnt vmcnt(6)
    buffer_load_dwordx4 v[176:179], v1, s[24:27], s58 offen offset:3328 nt
    v_cvt_f32_i32 v144, v144
    v_cvt_f32_i32 v145, v145
    v_cvt_f32_i32 v146, v146
    v_cvt_f32_i32 v147, v147
    v_cvt_pk_bf16_f32 v48, v144, v145
    v_cvt_pk_bf16_f32 v49, v146, v147
    s_cmp_gt_i32 s4, 18
    s_cbranch_scc1 L_kw4_2
    s_cmp_gt_i32 s4, 2
    s_cbranch_scc1 L_kw4_1
    s_cmp_lt_i32 s4, -2
    s_cbranch_scc0 L_kw4_0
    s_waitcnt vmcnt(3)
L_kw4_0:
    s_waitcnt vmcnt(4)
L_kw4_1:
    s_waitcnt vmcnt(5)
L_kw4_2:
    s_waitcnt vmcnt(6)
    buffer_load_dwordx4 v[180:183], v1, s[24:27], s58 offen offset:384 nt
    v_cvt_f32_i32 v148, v148
    v_cvt_f32_i32 v149, v149
    v_cvt_f32_i32 v150, v150
    v_cvt_f32_i32 v151, v151
    v_cvt_pk_bf16_f32 v38, v148, v149
    v_cvt_pk_bf16_f32 v39, v150, v151
    s_cmp_gt_i32 s4, 26
    s_cbranch_scc1 L_kw5_2
    s_cmp_gt_i32 s4, 10
    s_cbranch_scc1 L_kw5_1
L_kw5_0:
    s_waitcnt vmcnt(4)
L_kw5_1:
    s_waitcnt vmcnt(5)
L_kw5_2:
    s_waitcnt vmcnt(6)
    buffer_load_dwordx4 v[184:187], v1, s[24:27], s58 offen offset:1408 nt
    v_mfma_f32_16x16x32_bf16 v[52:55], v[36:39], v[16:19], v[32:35]
    v_mfma_f32_16x16x32_bf16 v[52:55], v[36:39], v[20:23], v[52:55]
    v_cvt_f32_i32 v152, v152
    v_cvt_f32_i32 v153, v153
    v_cvt_f32_i32 v154, v154
    v_cvt_f32_i32 v155, v155
    v_cvt_pk_bf16_f32 v42, v152, v153
    v_cvt_pk_bf16_f32 v43, v154, v155
    s_cmp_gt_i32 s4, 22
    s_cbranch_scc1 L_kw6_2
    s_cmp_gt_i32 s4, 6
    s_cbranch_scc1 L_kw6_1
L_kw6_0:
    s_waitcnt vmcnt(4)
L_kw6_1:
    s_waitcnt vmcnt(5)
L_kw6_2:
    s_waitcnt vmcnt(6)
    buffer_load_dwordx4 v[188:191], v1, s[24:27], s58 offen offset:2432 nt
    v_mfma_f32_16x16x32_bf16 v[56:59], v[40:43], v[16:19], v[32:35]
    v_mfma_f32_16x16x32_bf16 v[56:59], v[40:43], v[20:23], v[56:59]
    v_cvt_f32_i32 v156, v156
    v_cvt_f32_i32 v157, v157
    v_cvt_f32_i32 v158, v158
    v_cvt_f32_i32 v159, v159
    v_cvt_pk_bf16_f32 v46, v156, v157
    v_cvt_pk_bf16_f32 v47, v158, v159
    s_cmp_gt_i32 s4, 30
    s_cbranch_scc1 L_kw7_2
    s_cmp_gt_i32 s4, 14
    s_cbranch_scc1 L_kw7_1
L_kw7_0:
    s_waitcnt vmcnt(4)
L_kw7_1:
    s_waitcnt vmcnt(5)
L_kw7_2:
    s_waitcnt vmcnt(6)
    buffer_load_dwordx4 v[192:195], v1, s[24:27], s58 offen offset:3456 nt
    v_mfma_f32_16x16x32_bf16 v[60:63], v[44:47], v[16:19], v[32:35]
    v_mfma_f32_16x16x32_bf16 v[60:63], v[44:47], v[20:23], v[60:63]
    v_cvt_f32_i32 v160, v160
    v_cvt_f32_i32 v161, v161
    v_cvt_f32_i32 v162, v162
    v_cvt_f32_i32 v163, v163
    v_cvt_pk_bf16_f32 v50, v160, v161
    v_cvt_pk_bf16_f32 v51, v162, v163
    s_cmp_gt_i32 s4, 17
    s_cbranch_scc1 L_kw8_2
    s_cmp_gt_i32 s4, 1
    s_cbranch_scc1 L_kw8_1
    s_cmp_lt_i32 s4, -1
    s_cbranch_scc0 L_kw8_0
    s_waitcnt vmcnt(3)
L_kw8_0:
    s_waitcnt vmcnt(4)
L_kw8_1:
    s_waitcnt vmcnt(5)
L_kw8_2:
    s_waitcnt vmcnt(6)
    buffer_load_dwordx4 v[132:135], v3, s[96:99], s59 offen offset:0 nt
    v_mfma_f32_16x16x32_bf16 v[64:67], v[48:51], v[16:19], v[32:35]
    v_mfma_f32_16x16x32_bf16 v[64:67], v[48:51], v[20:23], v[64:67]
    s_cmp_lg_u32 s5, 0
    s_cbranch_scc1 L_ctlk
L_cbk:
    v_cvt_f32_i32 v164, v164
    v_cvt_f32_i32 v165, v165
    v_cvt_f32_i32 v166, v166
    v_cvt_f32_i32 v167, v167
    v_cvt_pk_bf16_f32 v36, v164, v165
    v_cvt_pk_bf16_f32 v37, v166, v167
    s_cmp_gt_i32 s4, 25
    s_cbranch_scc1 L_kw9_2
    s_cmp_gt_i32 s4, 9
    s_cbranch_scc1 L_kw9_1
L_kw9_0:
    s_waitcnt vmcnt(4)
L_kw9_1:
    s_waitcnt vmcnt(5)
L_kw9_2:
    s_waitcnt vmcnt(6)
    buffer_load_dwordx4 v[136:139], v3, s[96:99], s59 offen offset:1024 nt
    v_cvt_f32_i32 v168, v168
    v_cvt_f32_i32 v169, v169
    v_cvt_f32_i32 v170, v170
    v_cvt_f32_i32 v171, v171
    v_cvt_pk_bf16_f32 v40, v168, v169
    v_cvt_pk_bf16_f32 v41, v170, v171
    s_cmp_gt_i32 s4, 21
    s_cbranch_scc1 L_kw10_2
    s_cmp_gt_i32 s4, 5
    s_cbranch_scc1 L_kw10_1
L_kw10_0:
    s_waitcnt vmcnt(4)
L_kw10_1:
    s_waitcnt vmcnt(5)
L_kw10_2:
    s_waitcnt vmcnt(6)
    buffer_load_dwordx4 v[140:143], v3, s[96:99], s59 offen offset:2048 nt
    v_cvt_f32_i32 v172, v172
    v_cvt_f32_i32 v173, v173
    v_cvt_f32_i32 v174, v174
    v_cvt_f32_i32 v175, v175
    v_cvt_pk_bf16_f32 v44, v172, v173
    v_cvt_pk_bf16_f32 v45, v174, v175
    s_cmp_gt_i32 s4, 29
    s_cbranch_scc1 L_kw11_2
    s_cmp_gt_i32 s4, 13
    s_cbranch_scc1 L_kw11_1
L_kw11_0:
    s_waitcnt vmcnt(4)
L_kw11_1:
    s_waitcnt vmcnt(5)
L_kw11_2:
    s_waitcnt vmcnt(6)
    buffer_load_dwordx4 v[144:147], v3, s[96:99], s59 offen offset:3072 nt
    v_cvt_f32_i32 v176, v176
    v_cvt_f32_i32 v177, v177
    v_cvt_f32_i32 v178, v178
    v_cvt_f32_i32 v179, v179
    v_cvt_pk_bf16_f32 v48, v176, v177
    v_cvt_pk_bf16_f32 v49, v178, v179
    s_cmp_gt_i32 s4, 19
    s_cbranch_scc1 L_kw12_2
    s_cmp_gt_i32 s4, 3
    s_cbranch_scc1 L_kw12_1
    s_cmp_lt_i32 s4, -3
    s_cbranch_scc0 L_kw12_0
    s_waitcnt vmcnt(3)
L_kw12_0:
    s_waitcnt vmcnt(4)
L_kw12_1:
    s_waitcnt vmcnt(5)
L_kw12_2:
    s_waitcnt vmcnt(6)
    buffer_load_dwordx4 v[148:151], v3, s[96:99], s59 offen offset:128 nt
    v_cvt_f32_i32 v180, v180
    v_cvt_f32_i32 v181, v181
    v_cvt_f32_i32 v182, v182
    v_cvt_f32_i32 v183, v183
    v_cvt_pk_bf16_f32 v38, v180, v181
    v_cvt_pk_bf16_f32 v39, v182, v183
    s_cmp_gt_i32 s4, 27
    s_cbranch_scc1 L_kw13_2
    s_cmp_gt_i32 s4, 11
    s_cbranch_scc1 L_kw13_1
L_kw13_0:
    s_waitcnt vmcnt(4)
L_kw13_1:
    s_waitcnt vmcnt(5)
L_kw13_2:
    s_waitcnt vmcnt(6)
    buffer_load_dwordx4 v[152:155], v3, s[96:99], s59 offen offset:1152 nt
    v_mfma_f32_16x16x32_bf16 v[52:55], v[36:39], v[24:27], v[52:55]
    v_mfma_f32_16x16x32_bf16 v[52:55], v[36:39], v[28:31], v[52:55]
    v_cvt_f32_i32 v184, v184
    v_cvt_f32_i32 v185, v185
    v_cvt_f32_i32 v186, v186
    v_cvt_f32_i32 v187, v187
    v_cvt_pk_bf16_f32 v42, v184, v185
    v_cvt_pk_bf16_f32 v43, v186, v187
    s_cmp_gt_i32 s4, 23
    s_cbranch_scc1 L_kw14_2
    s_cmp_gt_i32 s4, 7
    s_cbranch_scc1 L_kw14_1
L_kw14_0:
    s_waitcnt vmcnt(4)
L_kw14_1:
    s_waitcnt vmcnt(5)
L_kw14_2:
    s_waitcnt vmcnt(6)
    buffer_load_dwordx4 v[156:159], v3, s[96:99], s59 offen offset:2176 nt
    v_mfma_f32_16x16x32_bf16 v[56:59], v[40:43], v[24:27], v[56:59]
    v_mfma_f32_16x16x32_bf16 v[56:59], v[40:43], v[28:31], v[56:59]
    s_memrealtime s[40:41]
    v_cvt_f32_i32 v188, v188
    v_cvt_f32_i32 v189, v189
    v_cvt_f32_i32 v190, v190
    v_cvt_f32_i32 v191, v191
    v_cvt_pk_bf16_f32 v46, v188, v189
    v_cvt_pk_bf16_f32 v47, v190, v191
    s_cmp_gt_i32 s4, 31
    s_cbranch_scc1 L_kw15_2
    s_cmp_gt_i32 s4, 15
    s_cbranch_scc1 L_kw15_1
L_kw15_0:
    s_waitcnt vmcnt(4)
L_kw15_1:
    s_waitcnt vmcnt(5)
L_kw15_2:
    s_waitcnt vmcnt(6)
    buffer_load_dwordx4 v[160:163], v3, s[96:99], s59 offen offset:3200 nt
    v_mfma_f32_16x16x32_bf16 v[60:63], v[44:47], v[24:27], v[60:63]
    v_mfma_f32_16x16x32_bf16 v[60:63], v[44:47], v[28:31], v[60:63]
    v_cvt_f32_i32 v192, v192
    v_cvt_f32_i32 v193, v193
    v_cvt_f32_i32 v194, v194
    v_cvt_f32_i32 v195, v195
    v_cvt_pk_bf16_f32 v50, v192, v193
    v_cvt_pk_bf16_f32 v51, v194, v195
    v_add_f32_dpp v68, v53, v52 row_ror:12 row_mask:0xf bank_mask:0xf
    v_add_f32_dpp v69, v57, v56 row_ror:12 row_mask:0xf bank_mask:0xf
    v_mfma_f32_16x16x32_bf16 v[64:67], v[48:51], v[24:27], v[64:67]
    v_add_f32_dpp v68, v54, v68 row_ror:8 row_mask:0xf bank_mask:0xf
    v_add_f32_dpp v69, v58, v69 row_ror:8 row_mask:0xf bank_mask:0xf
    v_mfma_f32_16x16x32_bf16 v[64:67], v[48:51], v[28:31], v[64:67]
    v_add_f32_dpp v68, v55, v68 row_ror:4 row_mask:0xf bank_mask:0xf
    v_add_f32_dpp v69, v59, v69 row_ror:4 row_mask:0xf bank_mask:0xf
    v_add_f32_dpp v70, v61, v60 row_ror:12 row_mask:0xf bank_mask:0xf
    s_mov_b32 s58, s59
    v_max3_f32 v8, v8, v68, v69
    v_add_f32_dpp v70, v62, v70 row_ror:8 row_mask:0xf bank_mask:0xf
    s_nop 1
    v_add_f32_dpp v70, v63, v70 row_ror:4 row_mask:0xf bank_mask:0xf
    v_add_f32_dpp v71, v65, v64 row_ror:12 row_mask:0xf bank_mask:0xf
    s_nop 1
    v_add_f32_dpp v71, v66, v71 row_ror:8 row_mask:0xf bank_mask:0xf
    s_nop 1
    v_add_f32_dpp v71, v67, v71 row_ror:4 row_mask:0xf bank_mask:0xf
    s_mov_b64 exec, s[66:67]
    v_max3_f32 v8, v8, v70, v71
    ds_write_b128 v6, v[68:71]
    s_mov_b64 exec, -1
    v_add_u32 v6, 256, v6
    s_cmp_lt_u32 s13, 32
    s_cbranch_scc1 L_kloop
    v_subrev_u32 v6, 0x2000, v6
    ds_read_b128 v[68:71], v6
    ds_read_b128 v[72:75], v5
    ds_read_b128 v[76:79], v5 offset:8192
    v_max_f32_dpp v8, v8, v8 quad_perm:[2,3,0,1] row_mask:0xf bank_mask:0xf
    v_mov_b32 v10, v8
    s_nop 1
    v_permlane16_swap_b32 v8, v10
    s_nop 1
    v_max_f32 v8, v8, v10
    v_mov_b32 v10, v8
    s_nop 1
    v_permlane32_swap_b32 v8, v10
    s_nop 1
    v_max_f32 v8, v8, v10
    s_mov_b32 s60, 0x4000
    v_readlane_b32 s62, v8, 0
    v_readlane_b32 s63, v8, 1
    s_nop 0
    s_nop 0
    v_mov_b32 v8, s62
    v_mov_b32 v10, s63
    v_cndmask_b32 v8, v8, v10, s[80:81]
    s_mov_b64 exec, 3
    ds_write_b32 v221, v8 offset:57376
    s_mov_b64 exec, 1
    ds_add_u32 v4, v92 offset:57408
    s_mov_b64 exec, -1
    .p2align 6
L_vloop:
    s_add_u32 s59, s58, s60
    s_xor_b32 s60, s60, 0x18000
    s_waitcnt lgkmcnt(0)
    s_lshl_b32 s11, s40, 5
    s_sub_u32 s11, s11, s12
    s_add_u32 s12, s12, s10
    s_and_b32 s11, s11, s29
    s_mov_b32 s4, 0
    s_cmp_gt_i32 s11, 1920
    s_cselect_b32 s4, 16, s4
    s_cmp_lt_i32 s11, -800
    s_cselect_b32 s4, -1, s4
    s_cmp_lt_i32 s11, -1600
    s_cselect_b32 s4, -2, s4
    s_cmp_lt_i32 s11, -2560
    s_cselect_b32 s4, -3, s4
    s_add_u32 s30, s30, 1
    s_min_u32 s30, s30, 4
    s_cmp_ge_u32 s30, 2
    s_cselect_b32 s63, 64, 0
    s_min_i32 s4, s4, s63
    s_cmp_gt_i32 s4, 0
    s_cselect_b32 s63, 2, 0
    s_sub_u32 s30, s30, s63
    s_cmp_gt_i32 s11, 2880
    s_cselect_b32 s4, 16, s4
    s_cmp_gt_i32 s4, 16
    s_cbranch_scc1 L_vw0_2
    s_cmp_gt_i32 s4, 0
    s_cbranch_scc1 L_vw0_1
    s_cmp_lt_i32 s4, 0
    s_cbranch_scc0 L_vw0_0
    s_waitcnt vmcnt(3)
L_vw0_0:
    s_waitcnt vmcnt(4)
L_vw0_1:
    s_waitcnt vmcnt(5)
L_vw0_2:
    s_waitcnt vmcnt(6)
    buffer_load_dwordx4 v[164:167], v3, s[96:99], s58 offen offset:256 nt
    s_bitcmp1_b64 s[92:93], s13
    s_cbranch_scc1 L_ckv
L_nckv:
    s_add_u32 s13, s13, 1
    v_cvt_f32_i32 v132, v132
    v_cvt_f32_i32 v133, v133
    v_cvt_f32_i32 v134, v134
    v_cvt_f32_i32 v135, v135
    v_sub_f32 v68, v68, v8
    v_sub_f32 v69, v69, v8
    v_sub_f32 v70, v70, v8
    v_sub_f32 v71, v71, v8
    v_exp_f32 v68, v68
    v_exp_f32 v69, v69
    s_cmp_gt_i32 s4, 24
    s_cbranch_scc1 L_vw1_2
    s_cmp_gt_i32 s4, 8
    s_cbranch_scc1 L_vw1_1
L_vw1_0:
    s_waitcnt vmcnt(4)
L_vw1_1:
    s_waitcnt vmcnt(5)
L_vw1_2:
    s_waitcnt vmcnt(6)
    buffer_load_dwordx4 v[168:171], v3, s[96:99], s58 offen offset:1280 nt
    v_cvt_f32_i32 v136, v136
    v_cvt_f32_i32 v137, v137
    v_cvt_f32_i32 v138, v138
    v_cvt_f32_i32 v139, v139
    v_cvt_pk_bf16_f32 v36, v132, v136
    v_cvt_pk_bf16_f32 v40, v133, v137
    v_cvt_pk_bf16_f32 v44, v134, v138
    v_cvt_pk_bf16_f32 v48, v135, v139
    v_exp_f32 v70, v70
    v_exp_f32 v71, v71
    s_cmp_gt_i32 s4, 20
    s_cbranch_scc1 L_vw2_2
    s_cmp_gt_i32 s4, 4
    s_cbranch_scc1 L_vw2_1
L_vw2_0:
    s_waitcnt vmcnt(4)
L_vw2_1:
    s_waitcnt vmcnt(5)
L_vw2_2:
    s_waitcnt vmcnt(6)
    buffer_load_dwordx4 v[172:175], v3, s[96:99], s58 offen offset:2304 nt
    v_cvt_f32_i32 v140, v140
    v_cvt_f32_i32 v141, v141
    v_cvt_f32_i32 v142, v142
    v_cvt_f32_i32 v143, v143
    v_perm_b32 v80, v72, v72, v12
    v_perm_b32 v81, v73, v73, v12
    v_perm_b32 v82, v74, v74, v12
    v_perm_b32 v83, v75, v75, v12
    v_mul_f32 v80, v68, v80
    v_mul_f32 v81, v69, v81
    v_mul_f32 v82, v70, v82
    v_mul_f32 v83, v71, v83
    s_cmp_gt_i32 s4, 28
    s_cbranch_scc1 L_vw3_2
    s_cmp_gt_i32 s4, 12
    s_cbranch_scc1 L_vw3_1
L_vw3_0:
    s_waitcnt vmcnt(4)
L_vw3_1:
    s_waitcnt vmcnt(5)
L_vw3_2:
    s_waitcnt vmcnt(6)
    buffer_load_dwordx4 v[176:179], v3, s[96:99], s58 offen offset:3328 nt
    v_cvt_f32_i32 v144, v144
    v_cvt_f32_i32 v145, v145
    v_cvt_f32_i32 v146, v146
    v_cvt_f32_i32 v147, v147
    v_cvt_pk_bf16_f32 v37, v140, v144
    v_cvt_pk_bf16_f32 v41, v141, v145
    v_cvt_pk_bf16_f32 v45, v142, v146
    v_cvt_pk_bf16_f32 v49, v143, v147
    v_cvt_pk_bf16_f32 v84, v80, v81
    v_cvt_pk_bf16_f32 v85, v82, v83
    v_perm_b32 v86, v77, v76, v13
    v_perm_b32 v87, v79, v78, v13
    s_cmp_gt_i32 s4, 18
    s_cbranch_scc1 L_vw4_2
    s_cmp_gt_i32 s4, 2
    s_cbranch_scc1 L_vw4_1
    s_cmp_lt_i32 s4, -2
    s_cbranch_scc0 L_vw4_0
    s_waitcnt vmcnt(3)
L_vw4_0:
    s_waitcnt vmcnt(4)
L_vw4_1:
    s_waitcnt vmcnt(5)
L_vw4_2:
    s_waitcnt vmcnt(6)
    buffer_load_dwordx4 v[180:183], v3, s[96:99], s58 offen offset:384 nt
    v_cvt_f32_i32 v148, v148
    v_cvt_f32_i32 v149, v149
    v_cvt_f32_i32 v150, v150
    v_cvt_f32_i32 v151, v151
    v_and_b32 v88, v14, v84
    v_and_b32 v89, v14, v85
    v_and_b32 v90, v15, v84
    v_and_b32 v91, v15, v85
    v_mfma_f32_16x16x16_bf16 v[128:131], v[86:87], v[84:85], v[128:131]
    s_cmp_gt_i32 s4, 26
    s_cbranch_scc1 L_vw5_2
    s_cmp_gt_i32 s4, 10
    s_cbranch_scc1 L_vw5_1
L_vw5_0:
    s_waitcnt vmcnt(4)
L_vw5_1:
    s_waitcnt vmcnt(5)
L_vw5_2:
    s_waitcnt vmcnt(6)
    buffer_load_dwordx4 v[184:187], v3, s[96:99], s58 offen offset:1408 nt
    v_cvt_f32_i32 v152, v152
    v_cvt_f32_i32 v153, v153
    v_cvt_f32_i32 v154, v154
    v_cvt_f32_i32 v155, v155
    v_cvt_pk_bf16_f32 v38, v148, v152
    v_cvt_pk_bf16_f32 v42, v149, v153
    v_cvt_pk_bf16_f32 v46, v150, v154
    v_cvt_pk_bf16_f32 v50, v151, v155
    v_add_f32 v68, v68, v69
    v_add_f32 v70, v70, v71
    v_add_f32 v9, v9, v68
    v_add_f32 v9, v9, v70
    s_cmp_gt_i32 s4, 22
    s_cbranch_scc1 L_vw6_2
    s_cmp_gt_i32 s4, 6
    s_cbranch_scc1 L_vw6_1
L_vw6_0:
    s_waitcnt vmcnt(4)
L_vw6_1:
    s_waitcnt vmcnt(5)
L_vw6_2:
    s_waitcnt vmcnt(6)
    buffer_load_dwordx4 v[188:191], v3, s[96:99], s58 offen offset:2432 nt
    v_cvt_f32_i32 v156, v156
    v_cvt_f32_i32 v157, v157
    v_cvt_f32_i32 v158, v158
    v_cvt_f32_i32 v159, v159
    v_add_u32 v6, 256, v6
    s_bfe_u32 s61, s59, 0xd0008
    v_add_u32 v5, s61, v2
    s_cmp_gt_i32 s4, 30
    s_cbranch_scc1 L_vw7_2
    s_cmp_gt_i32 s4, 14
    s_cbranch_scc1 L_vw7_1
L_vw7_0:
    s_waitcnt vmcnt(4)
L_vw7_1:
    s_waitcnt vmcnt(5)
L_vw7_2:
    s_waitcnt vmcnt(6)
    buffer_load_dwordx4 v[192:195], v3, s[96:99], s58 offen offset:3456 nt
    v_cvt_f32_i32 v160, v160
    v_cvt_f32_i32 v161, v161
    v_cvt_f32_i32 v162, v162
    v_cvt_f32_i32 v163, v163
    v_cvt_pk_bf16_f32 v39, v156, v160
    v_cvt_pk_bf16_f32 v43, v157, v161
    v_cvt_pk_bf16_f32 v47, v158, v162
    v_cvt_pk_bf16_f32 v51, v159, v163
    s_cmp_eq_u32 s13, 64
    s_cbranch_scc1 L_tail
    s_cmp_gt_i32 s4, 17
    s_cbranch_scc1 L_vw8_2
    s_cmp_gt_i32 s4, 1
    s_cbranch_scc1 L_vw8_1
    s_cmp_lt_i32 s4, -1
    s_cbranch_scc0 L_vw8_0
    s_waitcnt vmcnt(3)
L_vw8_0:
    s_waitcnt vmcnt(4)
L_vw8_1:
    s_waitcnt vmcnt(5)
L_vw8_2:
    s_waitcnt vmcnt(6)
    buffer_load_dwordx4 v[132:135], v3, s[96:99], s59 offen offset:0 nt
    v_mfma_f32_16x16x32_bf16 v[96:99], v[36:39], v[88:91], v[96:99]
    v_mfma_f32_16x16x32_bf16 v[100:103], v[40:43], v[88:91], v[100:103]
    v_mfma_f32_16x16x32_bf16 v[104:107], v[44:47], v[88:91], v[104:107]
    v_mfma_f32_16x16x32_bf16 v[108:111], v[48:51], v[88:91], v[108:111]
    s_cmp_lg_u32 s5, 0
    s_cbranch_scc1 L_ctlv
L_cbv:
    v_cvt_f32_i32 v164, v164
    v_cvt_f32_i32 v165, v165
    v_cvt_f32_i32 v166, v166
    v_cvt_f32_i32 v167, v167
    s_cmp_gt_i32 s4, 25
    s_cbranch_scc1 L_vw9_2
    s_cmp_gt_i32 s4, 9
    s_cbranch_scc1 L_vw9_1
L_vw9_0:
    s_waitcnt vmcnt(4)
L_vw9_1:
    s_waitcnt vmcnt(5)
L_vw9_2:
    s_waitcnt vmcnt(6)
    buffer_load_dwordx4 v[136:139], v3, s[96:99], s59 offen offset:1024 nt
    v_cvt_f32_i32 v168, v168
    v_cvt_f32_i32 v169, v169
    v_cvt_f32_i32 v170, v170
    v_cvt_f32_i32 v171, v171
    v_cvt_pk_bf16_f32 v36, v164, v168
    v_cvt_pk_bf16_f32 v40, v165, v169
    v_cvt_pk_bf16_f32 v44, v166, v170
    v_cvt_pk_bf16_f32 v48, v167, v171
    s_cmp_gt_i32 s4, 21
    s_cbranch_scc1 L_vw10_2
    s_cmp_gt_i32 s4, 5
    s_cbranch_scc1 L_vw10_1
L_vw10_0:
    s_waitcnt vmcnt(4)
L_vw10_1:
    s_waitcnt vmcnt(5)
L_vw10_2:
    s_waitcnt vmcnt(6)
    buffer_load_dwordx4 v[140:143], v3, s[96:99], s59 offen offset:2048 nt
    v_cvt_f32_i32 v172, v172
    v_cvt_f32_i32 v173, v173
    v_cvt_f32_i32 v174, v174
    v_cvt_f32_i32 v175, v175
    s_cmp_gt_i32 s4, 29
    s_cbranch_scc1 L_vw11_2
    s_cmp_gt_i32 s4, 13
    s_cbranch_scc1 L_vw11_1
L_vw11_0:
    s_waitcnt vmcnt(4)
L_vw11_1:
    s_waitcnt vmcnt(5)
L_vw11_2:
    s_waitcnt vmcnt(6)
    buffer_load_dwordx4 v[144:147], v3, s[96:99], s59 offen offset:3072 nt
    v_cvt_f32_i32 v176, v176
    v_cvt_f32_i32 v177, v177
    v_cvt_f32_i32 v178, v178
    v_cvt_f32_i32 v179, v179
    v_cvt_pk_bf16_f32 v37, v172, v176
    v_cvt_pk_bf16_f32 v41, v173, v177
    v_cvt_pk_bf16_f32 v45, v174, v178
    v_cvt_pk_bf16_f32 v49, v175, v179
    s_cmp_gt_i32 s4, 19
    s_cbranch_scc1 L_vw12_2
    s_cmp_gt_i32 s4, 3
    s_cbranch_scc1 L_vw12_1
    s_cmp_lt_i32 s4, -3
    s_cbranch_scc0 L_vw12_0
    s_waitcnt vmcnt(3)
L_vw12_0:
    s_waitcnt vmcnt(4)
L_vw12_1:
    s_waitcnt vmcnt(5)
L_vw12_2:
    s_waitcnt vmcnt(6)
    buffer_load_dwordx4 v[148:151], v3, s[96:99], s59 offen offset:128 nt
    v_cvt_f32_i32 v180, v180
    v_cvt_f32_i32 v181, v181
    v_cvt_f32_i32 v182, v182
    v_cvt_f32_i32 v183, v183
    ds_read_b128 v[68:71], v6
    ds_read_b128 v[72:75], v5
    ds_read_b128 v[76:79], v5 offset:8192
    s_cmp_gt_i32 s4, 27
    s_cbranch_scc1 L_vw13_2
    s_cmp_gt_i32 s4, 11
    s_cbranch_scc1 L_vw13_1
L_vw13_0:
    s_waitcnt vmcnt(4)
L_vw13_1:
    s_waitcnt vmcnt(5)
L_vw13_2:
    s_waitcnt vmcnt(6)
    buffer_load_dwordx4 v[152:155], v3, s[96:99], s59 offen offset:1152 nt
    v_cvt_f32_i32 v184, v184
    v_cvt_f32_i32 v185, v185
    v_cvt_f32_i32 v186, v186
    v_cvt_f32_i32 v187, v187
    v_cvt_pk_bf16_f32 v38, v180, v184
    v_cvt_pk_bf16_f32 v42, v181, v185
    v_cvt_pk_bf16_f32 v46, v182, v186
    v_cvt_pk_bf16_f32 v50, v183, v187
    s_cmp_gt_i32 s4, 23
    s_cbranch_scc1 L_vw14_2
    s_cmp_gt_i32 s4, 7
    s_cbranch_scc1 L_vw14_1
L_vw14_0:
    s_waitcnt vmcnt(4)
L_vw14_1:
    s_waitcnt vmcnt(5)
L_vw14_2:
    s_waitcnt vmcnt(6)
    buffer_load_dwordx4 v[156:159], v3, s[96:99], s59 offen offset:2176 nt
    s_memrealtime s[40:41]
    v_cvt_f32_i32 v188, v188
    v_cvt_f32_i32 v189, v189
    v_cvt_f32_i32 v190, v190
    v_cvt_f32_i32 v191, v191
    s_cmp_gt_i32 s4, 31
    s_cbranch_scc1 L_vw15_2
    s_cmp_gt_i32 s4, 15
    s_cbranch_scc1 L_vw15_1
L_vw15_0:
    s_waitcnt vmcnt(4)
L_vw15_1:
    s_waitcnt vmcnt(5)
L_vw15_2:
    s_waitcnt vmcnt(6)
    buffer_load_dwordx4 v[160:163], v3, s[96:99], s59 offen offset:3200 nt
    v_cvt_f32_i32 v192, v192
    v_cvt_f32_i32 v193, v193
    v_cvt_f32_i32 v194, v194
    v_cvt_f32_i32 v195, v195
    v_cvt_pk_bf16_f32 v39, v188, v192
    v_cvt_pk_bf16_f32 v43, v189, v193
    v_cvt_pk_bf16_f32 v47, v190, v194
    v_cvt_pk_bf16_f32 v51, v191, v195
    s_mov_b32 s58, s59
    s_nop 0
    v_mfma_f32_16x16x32_bf16 v[112:115], v[36:39], v[88:91], v[112:115]
    v_mfma_f32_16x16x32_bf16 v[116:119], v[40:43], v[88:91], v[116:119]
    v_mfma_f32_16x16x32_bf16 v[120:123], v[44:47], v[88:91], v[120:123]
    v_mfma_f32_16x16x32_bf16 v[124:127], v[48:51], v[88:91], v[124:127]
    s_branch L_vloop
L_tail:
    s_cmp_lg_u32 s50, 2
    s_cbranch_scc1 L_slow
L_tail2:
    v_mfma_f32_16x16x32_bf16 v[96:99], v[36:39], v[88:91], v[96:99]
    v_mfma_f32_16x16x32_bf16 v[100:103], v[40:43], v[88:91], v[100:103]
    v_mfma_f32_16x16x32_bf16 v[104:107], v[44:47], v[88:91], v[104:107]
    v_mfma_f32_16x16x32_bf16 v[108:111], v[48:51], v[88:91], v[108:111]
    v_add_f32_dpp v9, v9, v9 quad_perm:[2,3,0,1] row_mask:0xf bank_mask:0xf
    s_lshl_b32 s62, s56, 11
    s_add_u32 s62, s62, 49152
    v_and_b32 v16, 3, v7
    v_lshlrev_b32 v16, 9, v16
    v_bfe_u32 v17, v7, 2, 1
    v_lshl_add_u32 v16, v17, 7, v16
    v_bfe_u32 v17, v7, 4, 1
    v_lshl_add_u32 v16, v17, 6, v16
    v_add_u32 v16, s62, v16
    v_mul_f32 v222, v128, v220
    v_mov_b32 v10, v9
    s_nop 1
    v_permlane16_swap_b32 v9, v10
    s_nop 1
    v_add_f32 v9, v9, v10
    v_mov_b32 v10, v9
    s_nop 1
    v_permlane32_swap_b32 v9, v10
    s_nop 1
    v_add_f32 v9, v9, v10
    v_mul_f32 v9, v9, v220
    v_readlane_b32 s74, v228, 0
    v_readlane_b32 s61, v228, 1
    s_mov_b64 exec, s[82:83]
    v_fma_f32 v52, v96, v220, -v222
    v_fma_f32 v53, v100, v220, -v222
    v_fma_f32 v54, v104, v220, -v222
    v_fma_f32 v55, v108, v220, -v222
    ds_write_b128 v16, v[52:55] offset:0
    v_fma_f32 v56, v97, v220, -v222
    v_fma_f32 v57, v101, v220, -v222
    v_fma_f32 v58, v105, v220, -v222
    v_fma_f32 v59, v109, v220, -v222
    ds_write_b128 v16, v[56:59] offset:16
    v_fma_f32 v60, v98, v220, -v222
    v_fma_f32 v61, v102, v220, -v222
    v_fma_f32 v62, v106, v220, -v222
    v_fma_f32 v63, v110, v220, -v222
    ds_write_b128 v16, v[60:63] offset:32
    v_fma_f32 v64, v99, v220, -v222
    v_fma_f32 v65, v103, v220, -v222
    v_fma_f32 v66, v107, v220, -v222
    v_fma_f32 v67, v111, v220, -v222
    ds_write_b128 v16, v[64:67] offset:48
    s_mov_b64 exec, 3
    ds_write_b32 v221, v9 offset:57344
    s_mov_b64 exec, -1
    s_and_b32 s16, s2, 7
    s_lshl_b32 s62, s16, 1
    s_add_u32 s62, s62, s56
    s_lshl_b32 s63, s56, 3
    s_and_b32 s63, s63, 8
    s_cmp_lt_u32 s56, 2
    s_cselect_b32 s62, s62, s63
    s_cselect_b32 s63, 7, 63
    v_and_b32 v18, s63, v7
    v_lshl_add_u32 v18, s62, 3, v18
    v_lshlrev_b32 v19, 3, v18
    s_cmp_lt_u32 s62, 8
    s_cselect_b32 s74, s74, s61
    s_cselect_b32 s63, 0, 16
    v_mov_b32 v17, s63
    s_mul_i32 s73, s64, 16384
    s_add_u32 s73, s73, 0x80000
    s_mul_i32 s17, s16, 128
    s_add_u32 s17, s17, s73
    v_lshrrev_b32 v223, 3, v18
    v_and_b32 v224, 0x70, v94
    s_lshl_b32 s63, s51, 1
    v_add_u32 v223, s63, v223
    v_and_b32 v223, 15, v223
    v_lshl_add_u32 v223, v223, 10, v224
    s_add_u32 s62, s62, s63
    s_and_b32 s62, s62, 15
    s_lshl_b32 s62, s62, 10
    s_add_u32 s73, s73, s62
    s_lshl_b32 s16, s16, 3
    s_lshl_b64 s[48:49], 0xff, s16
    s_cmp_lt_u32 s56, 2
    s_cselect_b64 s[48:49], s[48:49], -1
    v_bfe_u32 v224, v7, 4, 1
    v_lshl_add_u32 v224, v18, 1, v224
    v_lshlrev_b32 v224, 1, v224
    v_mov_b32 v199, s51
    s_lshl_b32 s63, s64, 9
    s_mov_b32 s76, s18
    s_and_b32 s77, s19, 0xffff
    s_mov_b32 s78, 0x4000
    s_mov_b32 s79, 0x00020000
    s_waitcnt vmcnt(7)
    v_cvt_f32_i32 v164, v164
    v_cvt_f32_i32 v165, v165
    v_cvt_f32_i32 v166, v166
    v_cvt_f32_i32 v167, v167
    s_waitcnt vmcnt(6)
    v_cvt_f32_i32 v168, v168
    v_cvt_f32_i32 v169, v169
    v_cvt_f32_i32 v170, v170
    v_cvt_f32_i32 v171, v171
    v_cvt_pk_bf16_f32 v36, v164, v168
    v_cvt_pk_bf16_f32 v40, v165, v169
    v_cvt_pk_bf16_f32 v44, v166, v170
    v_cvt_pk_bf16_f32 v48, v167, v171
    s_waitcnt vmcnt(5)
    v_cvt_f32_i32 v172, v172
    v_cvt_f32_i32 v173, v173
    v_cvt_f32_i32 v174, v174
    v_cvt_f32_i32 v175, v175
    s_waitcnt vmcnt(4)
    v_cvt_f32_i32 v176, v176
    v_cvt_f32_i32 v177, v177
    v_cvt_f32_i32 v178, v178
    v_cvt_f32_i32 v179, v179
    v_cvt_pk_bf16_f32 v37, v172, v176
    v_cvt_pk_bf16_f32 v41, v173, v177
    v_cvt_pk_bf16_f32 v45, v174, v178
    v_cvt_pk_bf16_f32 v49, v175, v179
    s_waitcnt vmcnt(3)
    v_cvt_f32_i32 v180, v180
    v_cvt_f32_i32 v181, v181
    v_cvt_f32_i32 v182, v182
    v_cvt_f32_i32 v183, v183
    s_waitcnt vmcnt(2)
    v_cvt_f32_i32 v184, v184
    v_cvt_f32_i32 v185, v185
    v_cvt_f32_i32 v186, v186
    v_cvt_f32_i32 v187, v187
    v_cvt_pk_bf16_f32 v38, v180, v184
    v_cvt_pk_bf16_f32 v42, v181, v185
    v_cvt_pk_bf16_f32 v46, v182, v186
    v_cvt_pk_bf16_f32 v50, v183, v187
    s_waitcnt vmcnt(1)
    v_cvt_f32_i32 v188, v188
    v_cvt_f32_i32 v189, v189
    v_cvt_f32_i32 v190, v190
    v_cvt_f32_i32 v191, v191
    s_waitcnt vmcnt(0)
    v_cvt_f32_i32 v192, v192
    v_cvt_f32_i32 v193, v193
    v_cvt_f32_i32 v194, v194
    v_cvt_f32_i32 v195, v195
    v_cvt_pk_bf16_f32 v39, v188, v192
    v_cvt_pk_bf16_f32 v43, v189, v193
    v_cvt_pk_bf16_f32 v47, v190, v194
    v_cvt_pk_bf16_f32 v51, v191, v195
    s_nop 1
    v_mfma_f32_16x16x32_bf16 v[112:115], v[36:39], v[88:91], v[112:115]
    v_mfma_f32_16x16x32_bf16 v[116:119], v[40:43], v[88:91], v[116:119]
    v_mfma_f32_16x16x32_bf16 v[120:123], v[44:47], v[88:91], v[120:123]
    v_mfma_f32_16x16x32_bf16 v[124:127], v[48:51], v[88:91], v[124:127]
    s_not_b64 exec, s[48:49]
    s_cbranch_scc0 L_nop1
    buffer_load_dwordx4 v[196:199], v94, s[52:55], s73 offen sc1
L_nop1:
    s_mov_b64 exec, s[82:83]
    s_nop 6
    v_fma_f32 v20, v112, v220, -v222
    v_fma_f32 v21, v116, v220, -v222
    v_fma_f32 v22, v120, v220, -v222
    v_fma_f32 v23, v124, v220, -v222
    ds_write_b128 v16, v[20:23] offset:256
    v_fma_f32 v24, v113, v220, -v222
    v_fma_f32 v25, v117, v220, -v222
    v_fma_f32 v26, v121, v220, -v222
    v_fma_f32 v27, v125, v220, -v222
    ds_write_b128 v16, v[24:27] offset:272
    v_fma_f32 v28, v114, v220, -v222
    v_fma_f32 v29, v118, v220, -v222
    v_fma_f32 v30, v122, v220, -v222
    v_fma_f32 v31, v126, v220, -v222
    ds_write_b128 v16, v[28:31] offset:288
    v_fma_f32 v32, v115, v220, -v222
    v_fma_f32 v33, v119, v220, -v222
    v_fma_f32 v34, v123, v220, -v222
    v_fma_f32 v35, v127, v220, -v222
    ds_write_b128 v16, v[32:35] offset:304
    s_mov_b64 exec, s[48:49]
    s_waitcnt lgkmcnt(0)
    s_barrier
    ds_read_b128 v[64:67], v17 offset:57344
    ds_read2st64_b64 v[48:51], v19 offset0:96 offset1:98
    ds_read2st64_b64 v[52:55], v19 offset0:100 offset1:102
    ds_read2st64_b64 v[56:59], v19 offset0:104 offset1:106
    ds_read2st64_b64 v[60:63], v19 offset0:108 offset1:110
    s_waitcnt lgkmcnt(4)
    v_pk_add_f32 v[64:65], v[64:65], v[66:67]
    v_add_f32 v64, v64, v65
    s_waitcnt lgkmcnt(3)
    v_pk_add_f32 v[48:49], v[48:49], v[50:51]
    v_log_f32 v198, v64
    s_waitcnt lgkmcnt(2)
    v_pk_add_f32 v[52:53], v[52:53], v[54:55]
    v_rcp_f32 v64, v64
    s_waitcnt lgkmcnt(1)
    v_pk_add_f32 v[56:57], v[56:57], v[58:59]
    v_pk_add_f32 v[48:49], v[48:49], v[52:53]
    s_waitcnt lgkmcnt(0)
    v_pk_add_f32 v[60:61], v[60:61], v[62:63]
    v_add_f32 v198, s74, v198
    v_pk_add_f32 v[56:57], v[56:57], v[60:61]
    v_pk_add_f32 v[48:49], v[48:49], v[56:57]
    v_mul_f32 v196, v48, v64
    v_mul_f32 v197, v49, v64
    s_cmp_lt_u32 s56, 2
    s_cbranch_scc1 L_poll
    buffer_store_dwordx4 v[196:199], v223, s[52:55], s17 offen sc1
    s_endpgm
L_again:
    s_mov_b64 exec, vcc
    buffer_load_dwordx4 v[196:199], v94, s[52:55], s73 offen sc1
    s_branch L_poll2
L_poll:
    s_not_b64 exec, s[48:49]
L_poll2:
    s_waitcnt vmcnt(0)
    v_cmp_ne_u32 vcc, s51, v199
    s_cbranch_vccnz L_again
    s_mov_b64 exec, -1
    v_max_f32_dpp v64, v198, v198 row_ror:8 row_mask:0xf bank_mask:0xf
    v_mov_b32 v65, v64
    s_nop 1
    v_permlane16_swap_b32 v64, v65
    v_max_f32 v64, v64, v65
    v_mov_b32 v65, v64
    s_nop 1
    v_permlane32_swap_b32 v64, v65
    v_max_f32 v64, v64, v65
    v_sub_f32 v198, v198, v64
    v_exp_f32 v198, v198
    s_nop 0
    v_mul_f32 v196, v196, v198
    v_mul_f32 v197, v197, v198
    v_add_f32_dpp v64, v198, v198 row_ror:8 row_mask:0xf bank_mask:0xf
    v_add_f32_dpp v198, v198, v198 row_ror:8 row_mask:0xf bank_mask:0xf
    v_permlane16_swap_b32 v196, v197
    v_add_f32 v196, v196, v197
    v_permlane16_swap_b32 v198, v64
    v_add_f32 v65, v198, v64
    v_add_f32 v198, v198, v64
    v_add_f32_dpp v197, v196, v196 row_ror:8 row_mask:0xf bank_mask:0xf
    v_add_f32_dpp v196, v196, v196 row_ror:8 row_mask:0xf bank_mask:0xf
    v_permlane32_swap_b32 v198, v65
    v_add_f32 v198, v198, v65
    v_permlane32_swap_b32 v196, v197
    v_rcp_f32 v198, v198
    v_add_f32 v196, v196, v197
    s_mov_b64 exec, 0x00ff00ff
    v_mul_f32 v196, v196, v198
    v_cvt_pk_bf16_f32 v196, v196, v196
    buffer_store_short v196, v224, s[76:79], s63 offen
L_end:
    s_endpgm
L_init:
    v_mul_u32_u24 v213, 4352, v7
    s_mov_b64 exec, 0x7fff
    buffer_store_dwordx2 v[128:129], v213, s[52:55], s100 offen sc1
    s_mov_b64 exec, -1
    s_branch L_noinit
L_slow:
    s_load_dword s51, s[20:21], 0 glc
    v_and_b32 v220, 16, v221
    ds_read_b32 v225, v4 offset:57408
    ds_read_b128 v[228:231], v220 offset:57376
    s_waitcnt lgkmcnt(0)
    v_readfirstlane_b32 s62, v225
    v_max_f32 v228, v228, v229
    s_cmp_eq_u32 s51, 0
    s_cbranch_scc1 L_slow
    s_cmp_lg_u32 s62, 8
    s_cbranch_scc1 L_slow
    v_max3_f32 v228, v228, v230, v231
    v_sub_f32 v220, v8, v228
    v_exp_f32 v220, v220
    s_mov_b32 s50, 2
    s_branch L_tail2
L_lastk:
    s_mov_b32 s96, s8
    s_and_b32 s97, s9, 0xffff
    s_mov_b32 s59, s65
    v_lshrrev_b32 v213, 3, v205
    v_and_b32 v214, 7, v205
    v_lshlrev_b32 v214, 4, v214
    v_lshl_add_u32 v214, v213, 9, v214
    v_lshl_add_u32 v3, v206, 15, v214
L_copied:
    v_readfirstlane_b32 s62, v92
    s_cmp_ge_u32 s62, 4
    v_mov_b32 v92, 1
    s_cbranch_scc1 L_lastkb
    ds_read_b32 v92, v4 offset:57408
    s_waitcnt lgkmcnt(0)
    s_branch L_copied
L_ckk:
    s_bitcmp1_b32 s13, 0
    s_cbranch_scc1 L_oddk
    s_bitcmp1_b64 s[46:47], s13
    s_cbranch_scc1 L_pubk
    s_load_dwordx2 s[42:43], s[22:23], s101
    s_mov_b32 s5, 1
    s_add_u32 s101, s101, 4352
    s_branch L_nckk
L_pubk:
    s_mov_b32 s44, 1
    s_mov_b32 s45, s40
    s_atomic_add_x2 s[44:45], s[22:23], s100
    s_add_u32 s100, s100, 4352
    s_branch L_nckk
L_oddk:
    s_cmp_eq_u32 s13, 3
    s_cbranch_scc1 L_su1
    s_cmp_eq_u32 s13, 5
    s_cbranch_scc1 L_su2
    s_cmp_eq_u32 s13, 29
    s_cbranch_scc1 L_su3
    s_cmp_lg_u32 s13, 1
    s_cbranch_scc1 L_race
L_su0:
    v_lshrrev_b32 v213, 3, v205
    v_mul_u32_u24 v213, 0x0202, v213
    v_lshl_add_u32 v213, v213, 16, v213
    v_add_u32 v13, 0x05040100, v213
    v_mul_u32_u24 v213, 0x0202, v212
    v_lshlrev_b32 v213, 16, v213
    v_add_u32 v12, 0x01000c0c, v213
    v_bfe_u32 v213, v205, 2, 1
    v_sub_u32 v15, 0, v213
    v_not_b32 v14, v15
    v_lshlrev_b32 v2, 7, v206
    s_bfe_u32 s62, s65, 0xd0008
    v_add_u32 v2, 32768, v2
    v_add_u32 v5, s62, v2
    v_cmp_eq_u32 s[82:83], v212, v210
    v_cmp_gt_u32 vcc, 8, v205
    v_mov_b32 v9, 0
    s_and_b64 s[82:83], s[82:83], vcc
    s_mov_b32 s50, 0
    s_lshl_b32 s62, s56, 2
    v_lshl_add_u32 v221, v211, 4, s62
    s_cmp_eq_u32 s2, 0
    s_cselect_b32 s62, 0x22aa00, 0
    s_or_b32 s92, s92, s62
    s_branch L_nckk
L_su1:
    v_mov_b32 v92, 1
    s_mov_b64 exec, 1
    ds_add_u32 v4, v92 offset:57408
    s_mov_b64 exec, -1
    v_mov_b32 v96, 0
    v_mov_b32 v97, 0
    v_mov_b32 v98, 0
    v_mov_b32 v99, 0
    v_mov_b32 v100, 0
    v_mov_b32 v101, 0
    v_mov_b32 v102, 0
    v_mov_b32 v103, 0
    v_mov_b32 v104, 0
    v_mov_b32 v105, 0
    v_mov_b32 v106, 0
    v_mov_b32 v107, 0
    v_mov_b32 v108, 0
    v_mov_b32 v109, 0
    v_mov_b32 v110, 0
    v_mov_b32 v111, 0
    s_branch L_nckk
L_su2:
    v_mov_b32 v112, 0
    v_mov_b32 v113, 0
    v_mov_b32 v114, 0
    v_mov_b32 v115, 0
    v_mov_b32 v116, 0
    v_mov_b32 v117, 0
    v_mov_b32 v118, 0
    v_mov_b32 v119, 0
    v_mov_b32 v120, 0
    v_mov_b32 v121, 0
    v_mov_b32 v122, 0
    v_mov_b32 v123, 0
    v_mov_b32 v124, 0
    v_mov_b32 v125, 0
    v_mov_b32 v126, 0
    v_mov_b32 v127, 0
    s_branch L_nckk
L_su3:
    ds_read_b32 v92, v4 offset:57408
    s_branch L_nckk
L_race:
    s_cmp_eq_u32 s13, 21
    s_cbranch_scc1 L_tag
    s_lshr_b32 s61, s13, 1
    s_xor_b32 s61, s61, s56
    s_and_b32 s61, s61, 1
    s_lshl_b32 s62, s61, 6
    s_add_u32 s62, s62, s56
    s_lshl_b32 s62, s62, 7
    s_add_u32 s62, s62, 0x100000
    s_xor_b32 s63, s62, 0x2000
    s_cmp_eq_u32 s13, 9
    s_cselect_b32 s48, 1, 0
    s_mov_b32 s49, s48
    s_atomic_or s48, s[22:23], s62 glc
    s_atomic_or s49, s[22:23], s63 glc
    s_cbranch_scc1 L_nckk
    s_waitcnt lgkmcnt(1)
    s_and_b32 s62, s48, 1
    s_and_b32 s63, s49, 1
    s_sub_u32 s62, s62, s63
    s_sub_u32 s63, 0, s62
    s_cmp_eq_u32 s61, 0
    s_cselect_b32 s62, s62, s63
    v_mov_b32 v225, s62
    s_mov_b64 exec, 1
    ds_add_u32 v4, v225 offset:57412
    s_mov_b64 exec, -1
    s_branch L_nckk
L_tag:
    s_cmp_lg_u32 s56, 0
    s_cbranch_scc1 L_nckk
    ds_read_b32 v225, v4 offset:57412
    s_getreg_b32 s63, hwreg(HW_REG_XCC_ID)
    s_and_b32 s63, s63, 3
    s_andn2_b32 s51, s40, 15
    s_or_b32 s51, s51, s63
    s_waitcnt lgkmcnt(0)
    v_readfirstlane_b32 s62, v225
    s_cmp_gt_i32 s62, 0
    s_cselect_b32 s63, 8, 12
    s_or_b32 s51, s51, s63
    s_atomic_add s51, s[20:21], 0
    s_branch L_nckk
L_ctlk:
    s_mov_b32 s5, 0
    s_lshl_b32 s62, s40, 5
    s_mov_b32 s63, s28
    s_waitcnt lgkmcnt(0)
    s_sub_u32 s62, s62, s43
    s_cmp_lt_u32 s62, 64000
    s_cselect_b32 s28, s42, 0
    s_cmp_eq_u32 s28, 32
    s_cselect_b32 s28, 1, 0
    s_sub_u32 s62, s43, s3
    s_mov_b32 s3, s43
    s_and_b32 s63, s63, s28
    s_cbranch_scc0 L_cbk
    s_lshr_b32 s10, s62, 2
    s_mul_i32 s62, s10, 3
    s_add_u32 s12, s43, s62
    s_mov_b32 s29, -1
    s_branch L_cbk
L_ckv:
    s_bitcmp1_b32 s13, 0
    s_cbranch_scc1 L_oddv
    s_bitcmp1_b64 s[46:47], s13
    s_cbranch_scc1 L_pubv
    s_load_dwordx2 s[42:43], s[22:23], s101
    s_mov_b32 s5, 1
    s_add_u32 s101, s101, 4352
    s_branch L_nckv
L_pubv:
    s_mov_b32 s44, 1
    s_mov_b32 s45, s40
    s_atomic_add_x2 s[44:45], s[22:23], s100
    s_add_u32 s100, s100, 4352
    s_branch L_nckv
L_oddv:
    s_cmp_eq_u32 s13, 47
    s_cbranch_scc1 L_fs1
    s_load_dword s51, s[20:21], 0
    v_and_b32 v220, 16, v221
    ds_read_b32 v225, v4 offset:57408
    ds_read_b128 v[228:231], v220 offset:57376
    s_branch L_nckv
L_fs1:
    v_readfirstlane_b32 s62, v225
    v_max_f32 v228, v228, v229
    s_cmp_eq_u32 s51, 0
    s_cbranch_scc1 L_nckv
    s_cmp_lg_u32 s62, 8
    s_cbranch_scc1 L_nckv
    v_max3_f32 v228, v228, v230, v231
    v_sub_f32 v220, v8, v228
    v_exp_f32 v220, v220
    s_mov_b32 s50, 2
    s_branch L_nckv
L_ctlv:
    s_mov_b32 s5, 0
    s_lshl_b32 s62, s40, 5
    s_mov_b32 s63, s28
    s_waitcnt lgkmcnt(0)
    s_sub_u32 s62, s62, s43
    s_cmp_lt_u32 s62, 64000
    s_cselect_b32 s28, s42, 0
    s_cmp_eq_u32 s28, 32
    s_cselect_b32 s28, 1, 0
    s_sub_u32 s62, s43, s3
    s_mov_b32 s3, s43
    s_and_b32 s63, s63, s28
    s_cbranch_scc0 L_cbv
    s_lshr_b32 s10, s62, 2
    s_mul_i32 s62, s10, 3
    s_add_u32 s12, s43, s62
    s_mov_b32 s29, -1
L_last:
    s_branch L_cbv
.section .rodata,"a"
.p2align 6
.amdhsa_kernel standalone__kv_cache_quant_int4_int2_kv_with_per_channel_or_per_token_scales__decode_kernel
  .amdhsa_next_free_vgpr 256
  .amdhsa_next_free_sgpr 102
  .amdhsa_accum_offset 256
  .amdhsa_group_segment_fixed_size 0
  .amdhsa_kernarg_size 80
  .amdhsa_user_sgpr_count 2
  .amdhsa_user_sgpr_kernarg_segment_ptr 1
  .amdhsa_system_sgpr_workgroup_id_x 1
.end_amdhsa_kernel
```
